```python
import torch

def _softmax(x, axis=-1):
    return torch.softmax(x, dim=axis)
def _gelu(x):
    return torch.nn.functional.gelu(x, approximate="tanh")
def _silu(x):
    return torch.nn.functional.silu(x)
def _sigmoid(x):
    return torch.sigmoid(x)
def _layernorm(x, axis=-1, eps=1e-5):
    m = x.mean(dim=axis, keepdim=True)
    v = x.var(dim=axis, keepdim=True, unbiased=False)
    return (x - m) / torch.sqrt(v + eps)
def _scatter_add(tgt, idx, src, axis=0):
    return tgt.clone().index_add_(axis, idx, src)
def _segment_sum(src, seg, n):
    out = torch.zeros((n,) + src.shape[1:], dtype=src.dtype)
    return out.index_add_(0, seg, src)
def _pad(x, pw):
    flat = tuple(v for pair in reversed(pw) for v in pair)
    return torch.nn.functional.pad(x, flat)

kernel_name = 'parallel_sum__sliding_block_cached__glu_gated_glu__decode'

def setup_inputs():

    _w = (lambda a: (lambda t: t.to(torch.bfloat16) if t.is_floating_point() else t)(torch.as_tensor(a)))
    def _A_setup():
        B, Sq, D = 1, 1, 640
        Hq, Hkv, Sk, Dh = 32, 32, 8192, 128
        assert Hq % Hkv == 0, (Hq, Hkv)
        return {
            "x": _w((lambda *s: torch.randn(*s, dtype=torch.bfloat16) * 0.05)(B, Sq, D)),
            "k_cache": _w((lambda *s: torch.randn(*s, dtype=torch.bfloat16) * 3.2)(B, Hkv, Sk, Dh)),
            "v_cache": _w((lambda *s: torch.randn(*s, dtype=torch.bfloat16) * 1.6)(B, Hkv, Sk, Dh)),
            "wq": _w((lambda *s: torch.randn(*s, dtype=torch.bfloat16) * 3.2)(D, Hq * Dh) * (D ** -0.5)),
            "wo": _w((lambda *s: torch.randn(*s, dtype=torch.bfloat16) * 1.6)(Hq * Dh, D) * ((Hq * Dh) ** -0.5)),
        }
    _A_in = _A_setup()

    def _B_setup():
        B, S, D, F = 1, 1, 640, 1728
        return {
            "x": _w((lambda *s: torch.randn(*s, dtype=torch.bfloat16) * 0.05)(B, S, D)),
            "w_gate": _w((lambda *s: torch.randn(*s, dtype=torch.bfloat16) * 0.05)(D, F)),
            "w_up": _w((lambda *s: torch.randn(*s, dtype=torch.bfloat16) * 0.05)(D, F)),
            "w_down": _w((lambda *s: torch.randn(*s, dtype=torch.bfloat16) * 0.05)(F, D)),
        }
    _B_in = _B_setup()

    return {
        "A_x": _A_in["x"],
        "A_k_cache": _A_in["k_cache"],
        "A_v_cache": _A_in["v_cache"],
        "A_wq": _A_in["wq"],
        "A_wo": _A_in["wo"],
        "B_x": _B_in["x"],
        "B_w_gate": _B_in["w_gate"],
        "B_w_up": _B_in["w_up"],
        "B_w_down": _B_in["w_down"],
    }

def reference(A_x, A_k_cache, A_v_cache, A_wq, A_wo, B_x, B_w_gate, B_w_up, B_w_down):
    def _A_ref(x, k_cache, v_cache, wq, wo):
        B, Sq, D = x.shape
        Hq, Dh = 32, 128
        Hkv, Sk = k_cache.shape[1], k_cache.shape[2]
        W = min(4096, max(256, Sk // 4))
        rep = Hq // Hkv
        q = (lambda x, *d: x.permute(*d))((x @ wq).reshape(B, Sq, Hq, Dh), 0, 2, 1, 3)
        k = (lambda x, n, axis: torch.repeat_interleave(x, n, dim=axis))(k_cache[:, :, Sk - W:, :], rep, axis=1)
        v = (lambda x, n, axis: torch.repeat_interleave(x, n, dim=axis))(v_cache[:, :, Sk - W:, :], rep, axis=1)
        scores = torch.einsum("bhqd,bhkd->bhqk", q, k) * (Dh ** -0.5)
        p = _softmax(scores, axis=-1)
        o = torch.einsum("bhqk,bhkd->bhqd", p, v)
        return (lambda x, *d: x.permute(*d))(o, 0, 2, 1, 3).reshape(B, Sq, Hq * Dh) @ wo

    def _B_ref(x, w_gate, w_up, w_down):
        g = torch.einsum("bsd,df->bsf", x, w_gate)
        u = torch.einsum("bsd,df->bsf", x, w_up)
        h = _sigmoid(g) * u
        return torch.einsum("bsf,fd->bsd", h, w_down)

    x = A_x
    xn = _layernorm(x, axis=-1)
    return x + _A_ref(xn, A_k_cache, A_v_cache, A_wq, A_wo) + _B_ref(xn, B_w_gate, B_w_up, B_w_down)
```

```asm
; @launch grid=(256,1,1) block=(512,1,1) lds=8192
.amdgcn_target "amdgcn-amd-amdhsa--gfx950"
.text
.p2align 12
.fill 832, 4, 0xbf810000
.globl parallel_sum__sliding_block_cached__glu_gated_glu__decode_kernel
.p2align 8
.type parallel_sum__sliding_block_cached__glu_gated_glu__decode_kernel,@function
parallel_sum__sliding_block_cached__glu_gated_glu__decode_kernel:
    s_load_dwordx16 s[4:19], s[0:1], 0
    s_load_dwordx8 s[20:27], s[0:1], 64
    v_readfirstlane_b32 s3, v0
    s_cmp_ge_u32 s2, 256
    s_cbranch_scc1 L_end
    s_lshr_b32 s3, s3, 6
    v_and_b32 v0, 63, v0
    s_and_b32 s40, s2, 31
    s_lshr_b32 s41, s2, 5
    s_mov_b32 s31, 0x20000
    s_mov_b32 s42, 2000000
    s_mov_b32 s100, s40
    s_mov_b32 s101, s40
    s_cmp_ge_u32 s3, 4
    s_cbranch_scc1 L_main
    v_mov_b32 v13, 0
    ds_write_b32 v13, v13 offset:544
    s_cmp_ge_u32 s101, 27
    s_cselect_b32 s43, s3, 0
    s_cmp_ge_u32 s43, 2
    s_cbranch_scc1 L_idle
    s_cmp_lt_u32 s3, 2
    s_movk_i32 s50, 3456
    s_cselect_b32 s50, 8192, s50
    s_mul_i32 s43, s41, 80
    v_lshrrev_b32 v60, 3, v0
    v_add_u32 v1, s43, v60
    v_lshlrev_b32 v2, 4, v0
    v_lshlrev_b32 v61, 2, v0
    v_min_u32 v62, 39, v0
    v_lshlrev_b32 v62, 1, v62
    v_add_lshl_u32 v3, v62, s43, 1
    v_and_b32 v19, 0x70, v2
    v_mad_u32_u24 v1, v1, s50, v19
    s_lshl_b32 s50, s50, 3
    s_lshl_b32 s43, s3, 9
    s_add_u32 s43, s43, 5120
    v_lshl_add_u32 v62, v62, 2, s43
    v_lshl_add_u32 v60, v60, 2, s43
    s_lshl_b32 s43, s100, 8
    s_lshl_b32 s44, s3, 7
    s_add_u32 s43, s43, s44
    s_lshl_b32 s44, s101, 7
    s_sub_u32 s30, 2211840, s44
    s_sub_u32 s45, 5242880, s43
    s_cmp_lt_u32 s3, 2
    s_cselect_b32 s30, s45, s30
    s_cselect_b32 s43, s43, s44
    s_mov_b32 s44, 0
    s_waitcnt lgkmcnt(0)
    s_cselect_b32 s28, s10, s16
    s_cselect_b32 s29, s11, s17
    s_cmp_eq_u32 s3, 3
    s_cselect_b32 s28, s18, s28
    s_cselect_b32 s29, s19, s29
    s_add_u32 s28, s28, s43
    s_addc_u32 s29, s29, 0
    s_load_dword s51, s[26:27], 0xc0000
    buffer_load_dwordx4 v[20:23], v1, s[28:31], s44 offen nt
    s_add_u32 s44, s44, s50
    buffer_load_dwordx4 v[24:27], v1, s[28:31], s44 offen nt
    s_add_u32 s44, s44, s50
    buffer_load_dwordx4 v[28:31], v1, s[28:31], s44 offen nt
    s_add_u32 s44, s44, s50
    global_load_dwordx4 v[8:11], v2, s[4:5]
    global_load_dword v12, v61, s[4:5] offset:1024
    global_load_dword v14, v3, s[4:5]
    buffer_load_dwordx4 v[32:35], v1, s[28:31], s44 offen nt
    s_add_u32 s44, s44, s50
    buffer_load_dwordx4 v[36:39], v1, s[28:31], s44 offen nt
    s_add_u32 s44, s44, s50
    buffer_load_dwordx4 v[40:43], v1, s[28:31], s44 offen nt
    s_add_u32 s44, s44, s50
    buffer_load_dwordx4 v[44:47], v1, s[28:31], s44 offen nt
    s_add_u32 s44, s44, s50
    buffer_load_dwordx4 v[48:51], v1, s[28:31], s44 offen nt
    s_add_u32 s44, s44, s50
    v_and_b32 v2, 1, v0
    v_lshlrev_b32 v2, 4, v2
    v_mov_b32 v3, 0xffff
    v_lshlrev_b32 v2, v2, v3
    v_bfe_u32 v3, v0, 1, 2
    v_cmp_eq_u32 vcc, 0, v3
    s_nop 1
    v_cndmask_b32 v4, 0, v2, vcc
    v_cmp_eq_u32 vcc, 1, v3
    s_nop 1
    v_cndmask_b32 v5, 0, v2, vcc
    v_cmp_eq_u32 vcc, 2, v3
    s_nop 1
    v_cndmask_b32 v6, 0, v2, vcc
    v_cmp_eq_u32 vcc, 3, v3
    s_nop 1
    v_cndmask_b32 v7, 0, v2, vcc
    s_lshl_b32 s43, s40, 14
    s_add_u32 s46, s26, s43
    s_addc_u32 s47, s27, 0
    s_add_u32 s62, s46, 0x100000
    s_addc_u32 s63, s47, 0
    s_mov_b64 s[96:97], s[46:47]
    s_mov_b32 s98, 0
    s_waitcnt vmcnt(6)
    v_lshlrev_b32 v108, 16, v8
    v_and_b32 v109, 0xffff0000, v8
    v_lshlrev_b32 v110, 16, v9
    v_and_b32 v111, 0xffff0000, v9
    v_lshlrev_b32 v112, 16, v10
    v_and_b32 v113, 0xffff0000, v10
    v_lshlrev_b32 v114, 16, v11
    v_and_b32 v115, 0xffff0000, v11
    v_lshlrev_b32 v116, 16, v12
    v_and_b32 v117, 0xffff0000, v12
    v_add_f32 v2, v108, v109
    v_add_f32 v3, v110, v111
    v_add_f32 v2, v2, v112
    v_add_f32 v3, v3, v113
    v_add_f32 v2, v2, v114
    v_add_f32 v3, v3, v115
    v_add_f32 v2, v2, v116
    v_add_f32 v3, v3, v117
    v_add_f32 v2, v2, v3
    s_nop 1
    v_add_f32_dpp v2, v2, v2 quad_perm:[1,0,3,2] row_mask:0xf bank_mask:0xf
    s_nop 1
    v_add_f32_dpp v2, v2, v2 quad_perm:[2,3,0,1] row_mask:0xf bank_mask:0xf
    s_nop 1
    v_add_f32_dpp v2, v2, v2 row_half_mirror row_mask:0xf bank_mask:0xf
    s_nop 1
    v_add_f32_dpp v2, v2, v2 row_mirror row_mask:0xf bank_mask:0xf
    v_mov_b32 v3, v2
    s_nop 1
    v_permlane16_swap_b32 v3, v2
    v_add_f32 v2, v2, v3
    v_mov_b32 v3, v2
    s_nop 1
    v_permlane32_swap_b32 v3, v2
    v_add_f32 v2, v2, v3
    buffer_load_dwordx4 v[52:55], v1, s[28:31], s44 offen nt
    s_add_u32 s44, s44, s50
    v_mul_f32 v2, 0x3acccccd, v2
    v_sub_f32 v108, v108, v2
    v_sub_f32 v109, v109, v2
    v_sub_f32 v110, v110, v2
    v_sub_f32 v111, v111, v2
    v_sub_f32 v112, v112, v2
    v_sub_f32 v113, v113, v2
    v_sub_f32 v114, v114, v2
    v_sub_f32 v115, v115, v2
    v_sub_f32 v116, v116, v2
    v_sub_f32 v117, v117, v2
    v_mul_f32 v3, v108, v108
    v_mul_f32 v19, v109, v109
    v_fmac_f32 v3, v110, v110
    v_fmac_f32 v19, v111, v111
    v_fmac_f32 v3, v112, v112
    v_fmac_f32 v19, v113, v113
    v_fmac_f32 v3, v114, v114
    v_fmac_f32 v19, v115, v115
    v_fmac_f32 v3, v116, v116
    v_fmac_f32 v19, v117, v117
    v_add_f32 v3, v3, v19
    s_nop 1
    v_add_f32_dpp v3, v3, v3 quad_perm:[1,0,3,2] row_mask:0xf bank_mask:0xf
    s_nop 1
    v_add_f32_dpp v3, v3, v3 quad_perm:[2,3,0,1] row_mask:0xf bank_mask:0xf
    s_nop 1
    v_add_f32_dpp v3, v3, v3 row_half_mirror row_mask:0xf bank_mask:0xf
    s_nop 1
    v_add_f32_dpp v3, v3, v3 row_mirror row_mask:0xf bank_mask:0xf
    v_mov_b32 v19, v3
    s_nop 1
    v_permlane16_swap_b32 v19, v3
    v_add_f32 v3, v3, v19
    v_mov_b32 v19, v3
    s_nop 1
    v_permlane32_swap_b32 v19, v3
    v_add_f32 v3, v3, v19
    buffer_load_dwordx4 v[56:59], v1, s[28:31], s44 offen nt
    v_mul_f32 v3, 0x3acccccd, v3
    v_cvt_pk_bf16_f32 v2, v2, v2
    v_and_b32 v2, 0xffff0000, v2
    v_cvt_pk_bf16_f32 v3, v3, v3
    v_and_b32 v3, 0xffff0000, v3
    v_add_f32 v3, 0x3727c5ac, v3
    v_cvt_pk_bf16_f32 v3, v3, v3
    v_and_b32 v3, 0xffff0000, v3
    v_sqrt_f32 v3, v3
    s_nop 0
    v_cvt_pk_bf16_f32 v3, v3, v3
    v_and_b32 v3, 0xffff0000, v3
    v_rcp_f32 v3, v3
    s_waitcnt vmcnt(7)
    v_lshlrev_b32 v108, 16, v14
    v_and_b32 v109, 0xffff0000, v14
    v_sub_f32 v108, v108, v2
    v_sub_f32 v109, v109, v2
    v_cvt_pk_bf16_f32 v14, v108, v109
    v_lshlrev_b32 v108, 16, v14
    v_and_b32 v109, 0xffff0000, v14
    v_mul_f32 v108, v108, v3
    v_mul_f32 v109, v109, v3
    v_cvt_pk_bf16_f32 v14, v108, v108
    v_cvt_pk_bf16_f32 v15, v109, v109
    ds_write_b64 v62, v[14:15]
    ds_read2_b32 v[108:109], v60 offset0:0 offset1:8
    ds_read2_b32 v[110:111], v60 offset0:16 offset1:24
    ds_read2_b32 v[112:113], v60 offset0:32 offset1:40
    ds_read2_b32 v[114:115], v60 offset0:48 offset1:56
    ds_read2_b32 v[116:117], v60 offset0:64 offset1:72
    s_waitcnt lgkmcnt(0)
    v_and_b32 v68, v108, v4
    v_and_b32 v69, v108, v5
    v_and_b32 v70, v108, v6
    v_and_b32 v71, v108, v7
    v_and_b32 v72, v109, v4
    v_and_b32 v73, v109, v5
    v_and_b32 v74, v109, v6
    v_and_b32 v75, v109, v7
    v_and_b32 v76, v110, v4
    v_and_b32 v77, v110, v5
    v_and_b32 v78, v110, v6
    v_and_b32 v79, v110, v7
    v_and_b32 v80, v111, v4
    v_and_b32 v81, v111, v5
    v_and_b32 v82, v111, v6
    v_and_b32 v83, v111, v7
    v_and_b32 v84, v112, v4
    v_and_b32 v85, v112, v5
    v_and_b32 v86, v112, v6
    v_and_b32 v87, v112, v7
    v_and_b32 v88, v113, v4
    v_and_b32 v89, v113, v5
    v_and_b32 v90, v113, v6
    v_and_b32 v91, v113, v7
    v_and_b32 v92, v114, v4
    v_and_b32 v93, v114, v5
    v_and_b32 v94, v114, v6
    v_and_b32 v95, v114, v7
    v_and_b32 v96, v115, v4
    v_and_b32 v97, v115, v5
    v_and_b32 v98, v115, v6
    v_and_b32 v99, v115, v7
    v_and_b32 v100, v116, v4
    v_and_b32 v101, v116, v5
    v_and_b32 v102, v116, v6
    v_and_b32 v103, v116, v7
    v_and_b32 v104, v117, v4
    v_and_b32 v105, v117, v5
    v_and_b32 v106, v117, v6
    v_and_b32 v107, v117, v7
    s_waitcnt lgkmcnt(0)
    s_add_u32 s51, s51, 0x41041
    s_bfe_u32 s58, s51, 393216
    s_bfe_u32 s59, s51, 393222
    s_bfe_u32 s60, s51, 393228
    s_bfe_u32 s61, s51, 393234
    s_barrier
    s_getreg_b32 s52, hwreg(HW_REG_XCC_ID, 0, 4)
    s_mov_b32 s53, s58
    s_lshl_b32 s52, s52, 2
    s_xor_b32 s52, s52, s58
    s_mov_b32 s58, s52
    v_and_b32 v1, 7, v0
    v_lshlrev_b32 v1, 5, v1
    v_and_b32 v2, 16, v0
    v_add_u32 v1, v1, v2
    s_lshl_b32 s43, s41, 10
    s_lshl_b32 s44, s3, 8
    s_add_u32 s43, s43, s44
    v_add_u32 v1, s43, v1
    v_and_b32 v2, 15, v0
    v_lshlrev_b32 v2, 4, v2
    v_and_b32 v3, 8, v0
    v_lshl_add_u32 v3, v3, 4, v2
    s_lshl_b32 s43, s3, 7
    s_add_u32 s43, s43, 256
    s_cmp_lt_u32 s3, 2
    s_cselect_b64 vcc, -1, 0
    s_cselect_b32 s43, s44, s43
    v_cndmask_b32 v2, v3, v2, vcc
    v_lshrrev_b32 v3, 4, v0
    v_lshl_add_u32 v2, v3, 10, v2
    v_add_u32 v2, s43, v2
    v_add_u32 v10, 0x1000, v2
    s_waitcnt vmcnt(9)
    v_mfma_f32_16x16x32_bf16 v[124:127], v[68:71], v[20:23], 0
    s_waitcnt vmcnt(8)
    v_mfma_f32_16x16x32_bf16 v[124:127], v[72:75], v[24:27], v[124:127]
    s_waitcnt vmcnt(7)
    v_mfma_f32_16x16x32_bf16 v[124:127], v[76:79], v[28:31], v[124:127]
    s_waitcnt vmcnt(6)
    v_mfma_f32_16x16x32_bf16 v[124:127], v[80:83], v[32:35], v[124:127]
    s_waitcnt vmcnt(5)
    v_mfma_f32_16x16x32_bf16 v[124:127], v[84:87], v[36:39], v[124:127]
    s_waitcnt vmcnt(4)
    v_mfma_f32_16x16x32_bf16 v[124:127], v[88:91], v[40:43], v[124:127]
    s_waitcnt vmcnt(3)
    v_mfma_f32_16x16x32_bf16 v[124:127], v[92:95], v[44:47], v[124:127]
    s_waitcnt vmcnt(2)
    v_mfma_f32_16x16x32_bf16 v[124:127], v[96:99], v[48:51], v[124:127]
    s_waitcnt vmcnt(1)
    v_mfma_f32_16x16x32_bf16 v[124:127], v[100:103], v[52:55], v[124:127]
    s_waitcnt vmcnt(0)
    v_mfma_f32_16x16x32_bf16 v[124:127], v[104:107], v[56:59], v[124:127]
    s_nop 7
    v_permlane32_swap_b32 v124, v126
    v_permlane32_swap_b32 v125, v127
    s_nop 0
    v_add_f32_dpp v124, v126, v124 row_ror:8 row_mask:0xf bank_mask:0xf
    v_add_f32_dpp v125, v127, v125 row_ror:8 row_mask:0xf bank_mask:0xf
    s_nop 0
    v_permlane32_swap_b32 v124, v126
    v_permlane32_swap_b32 v125, v127
    v_bfi_b32 v124, 63, s58, v124
    v_bfi_b32 v125, 63, s59, v125
    v_bfi_b32 v126, 63, s60, v126
    v_bfi_b32 v127, 63, s61, v127
    s_mov_b64 exec, 0x00ff00ff
    global_store_dwordx4 v1, v[124:127], s[46:47]
    s_mov_b64 exec, -1
    s_cmp_lt_u32 s3, 2
    s_cbranch_scc0 L_verdict
L_g1:
    global_load_dwordx4 v[20:23], v2, s[96:97] sc1
    global_load_dwordx4 v[24:27], v10, s[96:97] sc1
    s_waitcnt vmcnt(0)
    v_xor_b32 v20, s58, v20
    v_xor_b32 v21, s59, v21
    v_xor_b32 v22, s60, v22
    v_xor_b32 v23, s61, v23
    v_xor_b32 v24, s58, v24
    v_xor_b32 v25, s59, v25
    v_xor_b32 v26, s60, v26
    v_xor_b32 v27, s61, v27
    v_or3_b32 v3, v20, v21, v22
    v_or3_b32 v3, v3, v23, v24
    v_or3_b32 v3, v3, v25, v26
    v_or_b32 v3, v3, v27
    v_and_b32 v3, 63, v3
    v_cmp_ne_u32 vcc, 0, v3
    s_cbranch_vccz L_g1_ok
    s_sub_i32 s42, s42, 1
    s_add_u32 s98, s98, 1
    s_and_b32 s99, s98, 31
    s_cselect_b64 s[96:97], s[46:47], s[62:63]
    s_cselect_b32 s58, s52, s53
    s_cbranch_scc1 L_g1_nb
    s_mov_b64 exec, 0x00ff00ff
    v_bfi_b32 v124, 63, s53, v124
    global_store_dwordx4 v1, v[124:127], s[62:63] sc1
    s_mov_b64 exec, -1
L_g1_nb:
    s_cmp_gt_i32 s42, 0
    s_cbranch_scc1 L_g1
L_g1_ok:
    v_add_f32 v20, v20, v24
    v_add_f32 v21, v21, v25
    v_add_f32 v22, v22, v26
    v_add_f32 v23, v23, v27
    s_nop 0
    v_permlane32_swap_b32 v20, v22
    v_permlane32_swap_b32 v21, v23
    v_add_f32 v20, v20, v22
    v_add_f32 v21, v21, v23
    s_nop 1
    v_permlane16_swap_b32 v20, v21
    v_add_f32 v20, v20, v21
    v_cvt_pk_bf16_f32 v20, v20, v20
    v_and_b32 v2, 15, v0
    v_lshrrev_b32 v3, 4, v0
    v_lshl_add_u32 v2, v2, 2, v3
    s_cmp_lt_u32 s3, 2
    s_cbranch_scc0 L_glu
    s_lshl_b32 s43, s3, 6
    v_add_lshl_u32 v2, v2, s43, 1
    ds_write_b16 v2, v20 offset:0
    s_branch L_b1
L_glu:
    v_and_b32 v20, 0xffff0000, v20
    v_mul_f32 v3, 0xbfb8aa3b, v20
    v_exp_f32 v3, v3
    s_lshl_b32 s43, s3, 5
    v_add_f32 v3, 1.0, v3
    v_rcp_f32 v3, v3
    s_sub_u32 s43, s43, 64
    v_cvt_pk_bf16_f32 v3, v3, v3
    v_and_b32 v3, 0xffff0000, v3
    s_nop 1
    v_mul_f32_dpp v3, v20, v3 row_ror:8 row_mask:0xf bank_mask:0xf
    v_add_lshl_u32 v2, v2, s43, 2
    v_cvt_pk_bf16_f32 v3, v3, v3
    s_mov_b32 exec_lo, 0x00ff00ff
    s_mov_b32 exec_hi, 0x00ff00ff
    ds_write_b32 v2, v3 offset:256
    s_waitcnt lgkmcnt(0)
    s_branch L_fdone
L_b1:
    s_cmp_eq_u32 s96, s46
    s_cselect_b32 s43, 1, 0x101
    s_mov_b64 exec, 1
    v_mov_b32 v2, s43
    ds_add_u32 v13, v2 offset:544
    v_mov_b32 v2, 1
    s_cmp_eq_u32 s3, 0
    s_cbranch_scc0 L_pf2
    v_mov_b32 v1, 589824
L_flag:
    global_load_dwordx4 v[20:23], v1, s[26:27] sc1
    s_waitcnt vmcnt(0)
    v_xor_b32 v20, s51, v20
    v_xor_b32 v21, s51, v21
    v_xor_b32 v22, s51, v22
    v_or3_b32 v3, v20, v21, v22
    v_cmp_ne_u32 vcc, 0, v3
    s_cbranch_vccz L_flag_ok
    s_sub_i32 s42, s42, 1
    s_cmp_gt_i32 s42, 0
    s_cbranch_scc1 L_flag
L_flag_ok:
L_fdone:
    s_mov_b64 exec, -1
    s_endpgm
L_pf2:
    s_mov_b64 exec, 31
    s_lshl_b32 s43, s41, 7
    s_add_u32 s43, s43, 0x2000
    v_lshl_add_u32 v1, v0, 10, s43
    global_load_dword v3, v1, s[46:47]
    s_cmp_eq_u32 s41, 7
    s_cbranch_scc0 L_fdone
    s_mov_b64 exec, 1
    global_atomic_add v3, v13, v2, s[24:25] sc0 sc1
    s_waitcnt vmcnt(0)
    v_and_b32 v3, 31, v3
    v_cmp_eq_u32 vcc, 31, v3
    s_cbranch_vccz L_fdone
    v_mov_b32 v1, 0xc0000
    v_mov_b32 v2, s51
    global_store_dword v1, v2, s[26:27] sc1
    s_branch L_fdone
L_verdict:
    s_sleep 4
    ds_read_b32 v3, v13 offset:544
    s_sub_i32 s42, s42, 1
    s_waitcnt lgkmcnt(0)
    v_readfirstlane_b32 s43, v3
    s_nop 0
    s_cmp_eq_u32 s43, 2
    s_cbranch_scc1 L_local
    s_cmp_lt_u32 s43, 2
    s_cselect_b32 s43, s42, 0
    s_cmp_gt_i32 s43, 0
    s_cbranch_scc1 L_verdict
    s_mov_b64 exec, 0x00ff00ff
    v_bfi_b32 v124, 63, s53, v124
    global_store_dwordx4 v1, v[124:127], s[62:63] sc1
    s_mov_b64 exec, -1
L_local:
    s_cmp_ge_u32 s41, 5
    s_cbranch_scc1 L_g1
    s_branch L_fdone
L_idle:
    s_waitcnt lgkmcnt(0)
    s_load_dword s51, s[26:27], 0xc0000
    s_lshl2_add_u32 s43, s2, s3
    s_cmp_eq_u32 s43, 111
    s_cbranch_scc1 L_init
    s_waitcnt lgkmcnt(0)
    s_barrier
    s_branch L_fdone
L_init:
    v_and_b32 v1, 62, v0
    v_lshlrev_b32 v1, 2, v1
    global_load_dwordx2 v[20:21], v1, s[4:5] offset:0
    global_load_dwordx2 v[22:23], v1, s[4:5] offset:256
    global_load_dwordx2 v[24:25], v1, s[4:5] offset:512
    global_load_dwordx2 v[26:27], v1, s[4:5] offset:768
    global_load_dwordx2 v[28:29], v1, s[4:5] offset:1024
    v_lshrrev_b32 v2, 2, v0
    v_lshlrev_b32 v2, 7, v2
    v_and_b32 v3, 3, v0
    v_lshl_add_u32 v2, v3, 4, v2
    v_add_u32 v2, 528384, v2
    v_add_u32 v3, 0x1000, v2
    v_and_b32 v1, 1, v0
    v_add_u32 v1, -1, v1
    v_lshlrev_b32 v19, 16, v1
    s_waitcnt vmcnt(0)
    v_lshlrev_b32 v108, 16, v20
    v_and_b32 v108, v108, v1
    v_and_b32 v109, v20, v19
    v_lshlrev_b32 v110, 16, v21
    v_and_b32 v110, v110, v1
    v_and_b32 v111, v21, v19
    global_store_dwordx4 v2, v[108:111], s[26:27] offset:-4096 sc1
    v_lshlrev_b32 v112, 16, v22
    v_and_b32 v112, v112, v1
    v_and_b32 v113, v22, v19
    v_lshlrev_b32 v114, 16, v23
    v_and_b32 v114, v114, v1
    v_and_b32 v115, v23, v19
    global_store_dwordx4 v2, v[112:115], s[26:27] offset:-2048 sc1
    v_lshlrev_b32 v116, 16, v24
    v_and_b32 v116, v116, v1
    v_and_b32 v117, v24, v19
    v_lshlrev_b32 v118, 16, v25
    v_and_b32 v118, v118, v1
    v_and_b32 v119, v25, v19
    global_store_dwordx4 v2, v[116:119], s[26:27] offset:0 sc1
    v_lshlrev_b32 v120, 16, v26
    v_and_b32 v120, v120, v1
    v_and_b32 v121, v26, v19
    v_lshlrev_b32 v122, 16, v27
    v_and_b32 v122, v122, v1
    v_and_b32 v123, v27, v19
    global_store_dwordx4 v2, v[120:123], s[26:27] offset:2048 sc1
    v_lshlrev_b32 v124, 16, v28
    v_and_b32 v124, v124, v1
    v_and_b32 v125, v28, v19
    v_lshlrev_b32 v126, 16, v29
    v_and_b32 v126, v126, v1
    v_and_b32 v127, v29, v19
    global_store_dwordx4 v3, v[124:127], s[26:27] offset:0 sc1
    s_waitcnt lgkmcnt(0)
    s_add_u32 s51, s51, 0x41041
    s_bfe_u32 s58, s51, 393216
    s_bfe_u32 s59, s51, 393222
    s_bfe_u32 s60, s51, 393228
    s_bfe_u32 s61, s51, 393234
    s_barrier
    v_mov_b32 v72, s51
    v_mov_b32 v73, s51
    v_mov_b32 v74, s51
    v_mov_b32 v75, s51
    v_mov_b32 v2, 589824
    s_waitcnt vmcnt(0)
    s_mov_b64 exec, 1
    global_store_dwordx4 v2, v[72:75], s[26:27] sc1
    s_mov_b64 exec, -1
    s_branch L_fdone
L_main:
    s_sub_u32 s3, s3, 4
    s_lshl_b32 s43, s3, 12
    v_lshl_add_u32 v1, v0, 4, s43
    s_lshl_b32 s43, s100, 21
    s_lshl_b32 s44, s41, 16
    s_add_u32 s43, s43, s44
    s_add_u32 s43, s43, 0x180000
    s_sub_u32 s30, 0x80000, s44
    s_mov_b32 s34, s30
    s_mov_b32 s35, 0x20000
    s_lshr_b32 s44, s2, 3
    s_add_u32 s44, s44, s2
    s_and_b32 s36, s44, 3
    s_lshl_b32 s36, s36, 14
    s_add_u32 s44, s44, 1
    s_and_b32 s37, s44, 3
    s_lshl_b32 s37, s37, 14
    s_add_u32 s44, s44, 1
    s_and_b32 s38, s44, 3
    s_lshl_b32 s38, s38, 14
    s_add_u32 s44, s44, 1
    s_and_b32 s39, s44, 3
    s_lshl_b32 s39, s39, 14
    s_waitcnt lgkmcnt(0)
    s_add_u32 s28, s6, s43
    s_addc_u32 s29, s7, 0
    s_add_u32 s32, s8, s43
    s_addc_u32 s33, s9, 0
    buffer_load_dwordx4 v[16:19], v1, s[28:31], s36 offen offset:0 nt
    buffer_load_dwordx4 v[20:23], v1, s[28:31], s36 offen offset:1024 nt
    s_load_dword s51, s[26:27], 0xc0000
    s_lshl_b32 s43, s40, 14
    s_add_u32 s46, s26, s43
    s_addc_u32 s47, s27, 0
    s_add_u32 s62, s46, 0x100000
    s_addc_u32 s63, s47, 0
    s_mov_b64 s[96:97], s[46:47]
    s_mov_b32 s98, 0
    v_and_b32 v2, 1, v0
    v_lshlrev_b32 v2, 4, v2
    v_mov_b32 v3, 0xffff
    v_lshlrev_b32 v2, v2, v3
    v_bfe_u32 v3, v0, 1, 2
    v_cmp_eq_u32 vcc, 0, v3
    s_nop 1
    v_cndmask_b32 v4, 0, v2, vcc
    v_cmp_eq_u32 vcc, 1, v3
    s_nop 1
    v_cndmask_b32 v5, 0, v2, vcc
    v_cmp_eq_u32 vcc, 2, v3
    s_nop 1
    v_cndmask_b32 v6, 0, v2, vcc
    v_cmp_eq_u32 vcc, 3, v3
    s_nop 1
    v_cndmask_b32 v7, 0, v2, vcc
    s_sub_u32 s53, s41, 5
    s_lshl_b32 s53, s53, 1
    s_lshr_b32 s43, s3, 1
    s_add_u32 s44, s53, s43
    s_lshl_b32 s43, s101, 1
    s_and_b32 s45, s3, 1
    s_add_u32 s43, s43, s45
    s_mov_b32 s14, 2211840
    s_cmp_lt_u32 s44, 5
    s_cselect_b32 s14, s14, 0
    s_cmp_lt_u32 s101, 27
    s_cselect_b32 s14, s14, 0
    s_cselect_b32 s52, 0, 2
    s_lshl2_add_u32 s45, s100, s3
    s_cmp_lt_u32 s41, 5
    s_cselect_b32 s52, 1, s52
    s_cselect_b32 s12, s12, s20
    s_cselect_b32 s13, s13, s21
    s_cselect_b32 s14, 5242880, s14
    s_cselect_b32 s43, s45, s43
    s_cselect_b32 s44, s41, s44
    s_cselect_b32 s53, s41, s53
    s_mov_b32 s15, 0x20000
    s_mul_i32 s43, s43, 40960
    s_lshl_b32 s44, s44, 8
    s_add_u32 s43, s43, s44
    s_mov_b32 s45, 0
    v_lshrrev_b32 v3, 4, v0
    v_and_b32 v2, 15, v0
    v_lshlrev_b32 v12, 4, v2
    s_movk_i32 s44, 1280
    v_mad_u32_u24 v200, v3, s44, v12
    v_add_u32 v200, s43, v200
    v_and_b32 v15, 7, v0
    v_lshl_add_u32 v15, v15, 2, v3
    s_and_b32 s43, s3, 1
    s_lshl_b32 s43, s43, 5
    v_add_lshl_u32 v15, v15, s43, 2
    v_lshlrev_b32 v204, 4, v0
    s_lshl_b32 s43, s3, 10
    s_add_u32 s43, s43, 0x2000
    v_add_u32 v201, s43, v204
    v_and_b32 v202, 0x380, v204
    v_add_u32 v202, 0x3000, v202
    v_and_b32 v14, 16, v0
    v_lshl_add_u32 v208, v2, 5, v14
    s_lshl_b32 s43, s3, 9
    v_add_u32 v208, s43, v208
    v_lshrrev_b32 v13, 3, v0
    v_and_b32 v14, 3, v0
    v_lshl_add_u32 v14, v13, 2, v14
    s_lshl_b32 s43, s3, 5
    v_add_lshl_u32 v209, v14, s43, 2
    s_lshl_b32 s44, s53, 7
    s_add_u32 s43, s43, s44
    v_add_lshl_u32 v210, v14, s43, 1
    v_lshlrev_b32 v205, 7, v3
    v_lshl_add_u32 v205, v2, 2, v205
    s_lshl_b32 s43, s43, 4
    s_add_u32 s43, s43, 524288
    v_add_u32 v205, s43, v205
    v_and_b32 v14, 0x70, v204
    s_lshl_b32 s43, s3, 7
    v_lshl_add_u32 v203, v0, 2, s43
    s_lshl_b32 s43, s41, 7
    s_add_u32 s43, s43, 0x2000
    s_lshl_b32 s44, s3, 10
    s_add_u32 s44, s44, s43
    v_lshl_add_u32 v206, v0, 2, s44
    s_add_u32 s43, s43, 0x1000
    v_add_u32 v207, s43, v14
    s_lshl_b32 s43, s3, 2
    v_mov_b32 v13, s43
    v_mov_b32 v14, 0
    s_mov_b32 s54, 0xcccccccc
    s_mov_b32 s55, 0xcccccccc
    s_mov_b32 s56, 0xaaaaaaaa
    s_mov_b32 s57, 0xaaaaaaaa
    s_lshl_b32 s16, s3, 1
    s_lshl_b32 s16, 3, s16
    s_mov_b32 s17, 0
    s_mov_b32 s48, 0x0f0f0f0f
    s_mov_b32 s49, 0x0f0f0f0f
    s_waitcnt lgkmcnt(0)
    s_add_u32 s51, s51, 0x41041
    s_bfe_u32 s58, s51, 393216
    s_bfe_u32 s59, s51, 393222
    s_bfe_u32 s60, s51, 393228
    s_bfe_u32 s61, s51, 393234
    v_and_b32 v2, 3, v0
    v_mul_u32_u24 v2, 6, v2
    v_lshrrev_b32 v211, v2, s51
    s_barrier
    buffer_load_dwordx4 v[24:27], v1, s[28:31], s36 offen offset:2048 nt
    buffer_load_dwordx4 v[28:31], v1, s[28:31], s36 offen offset:3072 nt
    buffer_load_dwordx4 v[32:35], v1, s[28:31], s37 offen offset:0 nt
    buffer_load_dwordx4 v[36:39], v1, s[28:31], s37 offen offset:1024 nt
    s_waitcnt vmcnt(5)
    buffer_load_dwordx4 v[40:43], v1, s[28:31], s37 offen offset:2048 nt
    s_waitcnt vmcnt(5)
    buffer_load_dwordx4 v[44:47], v1, s[28:31], s37 offen offset:3072 nt
    s_waitcnt vmcnt(5)
    buffer_load_dwordx4 v[48:51], v1, s[28:31], s38 offen offset:0 nt
    s_waitcnt vmcnt(5)
    buffer_load_dwordx4 v[52:55], v1, s[28:31], s38 offen offset:1024 nt
    s_waitcnt vmcnt(5)
    buffer_load_dwordx4 v[56:59], v1, s[28:31], s38 offen offset:2048 nt
    s_waitcnt vmcnt(5)
    buffer_load_dwordx4 v[60:63], v1, s[28:31], s38 offen offset:3072 nt
    s_waitcnt vmcnt(5)
    buffer_load_dwordx4 v[64:67], v1, s[28:31], s39 offen offset:0 nt
    s_waitcnt vmcnt(5)
    buffer_load_dwordx4 v[68:71], v1, s[28:31], s39 offen offset:1024 nt
    s_waitcnt vmcnt(5)
    buffer_load_dwordx4 v[72:75], v1, s[28:31], s39 offen offset:2048 nt
    s_waitcnt vmcnt(5)
    buffer_load_dwordx4 v[76:79], v1, s[28:31], s39 offen offset:3072 nt
    s_waitcnt vmcnt(5)
    buffer_load_dwordx4 v[80:83], v1, s[32:35], s36 offen offset:0 nt
    s_waitcnt vmcnt(5)
    buffer_load_dwordx4 v[84:87], v1, s[32:35], s36 offen offset:1024 nt
    s_waitcnt vmcnt(5)
    buffer_load_dwordx4 v[88:91], v1, s[32:35], s36 offen offset:2048 nt
    s_waitcnt vmcnt(5)
    buffer_load_dwordx4 v[92:95], v1, s[32:35], s36 offen offset:3072 nt
    s_waitcnt vmcnt(5)
    buffer_load_dwordx4 v[96:99], v1, s[32:35], s37 offen offset:0 nt
    s_waitcnt vmcnt(5)
    buffer_load_dwordx4 v[100:103], v1, s[32:35], s37 offen offset:1024 nt
L_qwait:
    ds_read_b32 v2, v14 offset:544
    ds_read_b128 v[8:11], v12 offset:0
    s_waitcnt lgkmcnt(0)
    v_readfirstlane_b32 s50, v2
    s_nop 0
    s_and_b32 s43, s50, 0xff
    s_cmp_eq_u32 s43, 2
    s_cbranch_scc1 L_qok
    s_sleep 1
    s_sub_i32 s42, s42, 1
    s_cmp_gt_i32 s42, 0
    s_cbranch_scc1 L_qwait
L_qok:
    v_dot2_f32_bf16 v144, v16, v8, 0
    v_dot2_f32_bf16 v145, v20, v8, 0
    v_dot2_f32_bf16 v146, v24, v8, 0
    v_dot2_f32_bf16 v147, v28, v8, 0
    v_dot2_f32_bf16 v144, v17, v9, v144
    v_dot2_f32_bf16 v145, v21, v9, v145
    v_dot2_f32_bf16 v146, v25, v9, v146
    v_dot2_f32_bf16 v147, v29, v9, v147
    v_dot2_f32_bf16 v144, v18, v10, v144
    v_dot2_f32_bf16 v145, v22, v10, v145
    v_dot2_f32_bf16 v146, v26, v10, v146
    v_dot2_f32_bf16 v147, v30, v10, v147
    v_dot2_f32_bf16 v144, v19, v11, v144
    v_dot2_f32_bf16 v145, v23, v11, v145
    v_dot2_f32_bf16 v146, v27, v11, v146
    v_dot2_f32_bf16 v147, v31, v11, v147
    v_dot2_f32_bf16 v148, v32, v8, 0
    v_dot2_f32_bf16 v149, v36, v8, 0
    v_dot2_f32_bf16 v150, v40, v8, 0
    v_dot2_f32_bf16 v151, v44, v8, 0
    v_dot2_f32_bf16 v148, v33, v9, v148
    v_dot2_f32_bf16 v149, v37, v9, v149
    v_dot2_f32_bf16 v150, v41, v9, v150
    v_dot2_f32_bf16 v151, v45, v9, v151
    v_dot2_f32_bf16 v148, v34, v10, v148
    v_dot2_f32_bf16 v149, v38, v10, v149
    v_dot2_f32_bf16 v150, v42, v10, v150
    v_dot2_f32_bf16 v151, v46, v10, v151
    v_dot2_f32_bf16 v148, v35, v11, v148
    v_dot2_f32_bf16 v149, v39, v11, v149
    v_dot2_f32_bf16 v150, v43, v11, v150
    v_dot2_f32_bf16 v151, v47, v11, v151
    s_waitcnt vmcnt(5)
    buffer_load_dwordx4 v[104:107], v1, s[32:35], s37 offen offset:2048 nt
    v_dot2_f32_bf16 v152, v48, v8, 0
    v_dot2_f32_bf16 v153, v52, v8, 0
    v_dot2_f32_bf16 v154, v56, v8, 0
    v_dot2_f32_bf16 v155, v60, v8, 0
    v_dot2_f32_bf16 v152, v49, v9, v152
    v_dot2_f32_bf16 v153, v53, v9, v153
    v_dot2_f32_bf16 v154, v57, v9, v154
    v_dot2_f32_bf16 v155, v61, v9, v155
    v_dot2_f32_bf16 v152, v50, v10, v152
    v_dot2_f32_bf16 v153, v54, v10, v153
    v_dot2_f32_bf16 v154, v58, v10, v154
    v_dot2_f32_bf16 v155, v62, v10, v155
    v_dot2_f32_bf16 v152, v51, v11, v152
    v_dot2_f32_bf16 v153, v55, v11, v153
    v_dot2_f32_bf16 v154, v59, v11, v154
    v_dot2_f32_bf16 v155, v63, v11, v155
    v_dot2_f32_bf16 v156, v64, v8, 0
    v_dot2_f32_bf16 v157, v68, v8, 0
    v_dot2_f32_bf16 v158, v72, v8, 0
    v_dot2_f32_bf16 v159, v76, v8, 0
    v_dot2_f32_bf16 v156, v65, v9, v156
    v_dot2_f32_bf16 v157, v69, v9, v157
    v_dot2_f32_bf16 v158, v73, v9, v158
    v_dot2_f32_bf16 v159, v77, v9, v159
    v_dot2_f32_bf16 v156, v66, v10, v156
    v_dot2_f32_bf16 v157, v70, v10, v157
    v_dot2_f32_bf16 v158, v74, v10, v158
    v_dot2_f32_bf16 v159, v78, v10, v159
    v_dot2_f32_bf16 v156, v67, v11, v156
    v_dot2_f32_bf16 v157, v71, v11, v157
    v_dot2_f32_bf16 v158, v75, v11, v158
    v_dot2_f32_bf16 v159, v79, v11, v159
    s_waitcnt vmcnt(5)
    buffer_load_dwordx4 v[108:111], v1, s[32:35], s37 offen offset:3072 nt
    v_add_f32_dpp v144, v144, v144 row_ror:8 row_mask:0xf bank_mask:0x3
    v_add_f32_dpp v145, v145, v145 row_ror:8 row_mask:0xf bank_mask:0x3
    v_add_f32_dpp v146, v146, v146 row_ror:8 row_mask:0xf bank_mask:0x3
    v_add_f32_dpp v147, v147, v147 row_ror:8 row_mask:0xf bank_mask:0x3
    v_add_f32_dpp v148, v148, v148 row_ror:8 row_mask:0xf bank_mask:0x3
    v_add_f32_dpp v149, v149, v149 row_ror:8 row_mask:0xf bank_mask:0x3
    v_add_f32_dpp v150, v150, v150 row_ror:8 row_mask:0xf bank_mask:0x3
    v_add_f32_dpp v151, v151, v151 row_ror:8 row_mask:0xf bank_mask:0x3
    v_add_f32_dpp v144, v152, v152 row_ror:8 row_mask:0xf bank_mask:0xc
    v_add_f32_dpp v145, v153, v153 row_ror:8 row_mask:0xf bank_mask:0xc
    v_add_f32_dpp v146, v154, v154 row_ror:8 row_mask:0xf bank_mask:0xc
    v_add_f32_dpp v147, v155, v155 row_ror:8 row_mask:0xf bank_mask:0xc
    v_add_f32_dpp v148, v156, v156 row_ror:8 row_mask:0xf bank_mask:0xc
    v_add_f32_dpp v149, v157, v157 row_ror:8 row_mask:0xf bank_mask:0xc
    v_add_f32_dpp v150, v158, v158 row_ror:8 row_mask:0xf bank_mask:0xc
    v_add_f32_dpp v151, v159, v159 row_ror:8 row_mask:0xf bank_mask:0xc
    v_add_f32_dpp v144, v144, v144 row_shl:4 row_mask:0xf bank_mask:0x5
    v_add_f32_dpp v145, v145, v145 row_shl:4 row_mask:0xf bank_mask:0x5
    v_add_f32_dpp v146, v146, v146 row_shl:4 row_mask:0xf bank_mask:0x5
    v_add_f32_dpp v147, v147, v147 row_shl:4 row_mask:0xf bank_mask:0x5
    v_add_f32_dpp v144, v148, v148 row_shr:4 row_mask:0xf bank_mask:0xa
    v_add_f32_dpp v145, v149, v149 row_shr:4 row_mask:0xf bank_mask:0xa
    v_add_f32_dpp v146, v150, v150 row_shr:4 row_mask:0xf bank_mask:0xa
    v_add_f32_dpp v147, v151, v151 row_shr:4 row_mask:0xf bank_mask:0xa
    v_add_f32_dpp v144, v144, v144 quad_perm:[2,3,0,1] row_mask:0xf bank_mask:0xf
    v_add_f32_dpp v145, v145, v145 quad_perm:[2,3,0,1] row_mask:0xf bank_mask:0xf
    v_add_f32_dpp v146, v146, v146 quad_perm:[2,3,0,1] row_mask:0xf bank_mask:0xf
    v_add_f32_dpp v147, v147, v147 quad_perm:[2,3,0,1] row_mask:0xf bank_mask:0xf
    v_cndmask_b32 v144, v144, v146, s[54:55]
    v_cndmask_b32 v145, v145, v147, s[54:55]
    s_nop 0
    v_add_f32_dpp v144, v144, v144 quad_perm:[1,0,3,2] row_mask:0xf bank_mask:0xf
    v_add_f32_dpp v145, v145, v145 quad_perm:[1,0,3,2] row_mask:0xf bank_mask:0xf
    v_cndmask_b32 v144, v144, v145, s[56:57]
    v_cvt_pk_bf16_f32 v144, v144, v144
    v_and_b32 v144, 0xffff0000, v144
    v_mul_f32 v144, 0x3db504f3, v144
    v_cvt_pk_bf16_f32 v144, v144, v144
    v_and_b32 v144, 0xffff0000, v144
    v_mov_b32 v2, v144
    s_waitcnt vmcnt(5)
    buffer_load_dwordx4 v[112:115], v1, s[32:35], s38 offen offset:0 nt
    v_max_f32_dpp v2, v2, v2 quad_perm:[1,0,3,2] row_mask:0xf bank_mask:0xf
    s_nop 1
    v_max_f32_dpp v2, v2, v2 quad_perm:[2,3,0,1] row_mask:0xf bank_mask:0xf
    s_nop 1
    v_max_f32_dpp v2, v2, v2 row_half_mirror row_mask:0xf bank_mask:0xf
    s_nop 1
    v_max_f32_dpp v2, v2, v2 row_mirror row_mask:0xf bank_mask:0xf
    v_mov_b32 v3, v2
    s_nop 1
    v_permlane16_swap_b32 v3, v2
    v_max_f32 v2, v2, v3
    v_mov_b32 v3, v2
    s_nop 1
    v_permlane32_swap_b32 v3, v2
    v_max_f32 v2, v2, v3
    ds_write_b32 v13, v2 offset:512
    v_sub_f32 v144, v144, v2
    v_mul_f32 v144, 0x3fb8aa3b, v144
    v_exp_f32 v3, v144
    s_nop 0
    v_cvt_pk_bf16_f32 v144, v3, v3
    s_nop 1
    v_and_b32_dpp v16, v144, v4 row_newbcast:0 row_mask:0xf bank_mask:0xf
    v_and_b32_dpp v17, v144, v5 row_newbcast:0 row_mask:0xf bank_mask:0xf
    v_and_b32_dpp v18, v144, v6 row_newbcast:0 row_mask:0xf bank_mask:0xf
    v_and_b32_dpp v19, v144, v7 row_newbcast:0 row_mask:0xf bank_mask:0xf
    v_add_f32_dpp v3, v3, v3 quad_perm:[1,0,3,2] row_mask:0xf bank_mask:0xf
    v_and_b32_dpp v20, v144, v4 row_newbcast:1 row_mask:0xf bank_mask:0xf
    v_and_b32_dpp v21, v144, v5 row_newbcast:1 row_mask:0xf bank_mask:0xf
    v_and_b32_dpp v22, v144, v6 row_newbcast:1 row_mask:0xf bank_mask:0xf
    v_and_b32_dpp v23, v144, v7 row_newbcast:1 row_mask:0xf bank_mask:0xf
    v_add_f32_dpp v3, v3, v3 quad_perm:[2,3,0,1] row_mask:0xf bank_mask:0xf
    v_and_b32_dpp v24, v144, v4 row_newbcast:2 row_mask:0xf bank_mask:0xf
    v_and_b32_dpp v25, v144, v5 row_newbcast:2 row_mask:0xf bank_mask:0xf
    v_and_b32_dpp v26, v144, v6 row_newbcast:2 row_mask:0xf bank_mask:0xf
    v_and_b32_dpp v27, v144, v7 row_newbcast:2 row_mask:0xf bank_mask:0xf
    v_add_f32_dpp v3, v3, v3 row_half_mirror row_mask:0xf bank_mask:0xf
    v_and_b32_dpp v28, v144, v4 row_newbcast:3 row_mask:0xf bank_mask:0xf
    v_and_b32_dpp v29, v144, v5 row_newbcast:3 row_mask:0xf bank_mask:0xf
    v_and_b32_dpp v30, v144, v6 row_newbcast:3 row_mask:0xf bank_mask:0xf
    v_and_b32_dpp v31, v144, v7 row_newbcast:3 row_mask:0xf bank_mask:0xf
    v_add_f32_dpp v3, v3, v3 row_mirror row_mask:0xf bank_mask:0xf
    s_waitcnt vmcnt(5)
    buffer_load_dwordx4 v[116:119], v1, s[32:35], s38 offen offset:1024 nt
    v_and_b32_dpp v32, v144, v4 row_newbcast:4 row_mask:0xf bank_mask:0xf
    v_and_b32_dpp v33, v144, v5 row_newbcast:4 row_mask:0xf bank_mask:0xf
    v_and_b32_dpp v34, v144, v6 row_newbcast:4 row_mask:0xf bank_mask:0xf
    v_and_b32_dpp v35, v144, v7 row_newbcast:4 row_mask:0xf bank_mask:0xf
    v_mov_b32 v145, v3
    v_and_b32_dpp v36, v144, v4 row_newbcast:5 row_mask:0xf bank_mask:0xf
    v_and_b32_dpp v37, v144, v5 row_newbcast:5 row_mask:0xf bank_mask:0xf
    v_and_b32_dpp v38, v144, v6 row_newbcast:5 row_mask:0xf bank_mask:0xf
    v_and_b32_dpp v39, v144, v7 row_newbcast:5 row_mask:0xf bank_mask:0xf
    v_permlane16_swap_b32 v145, v3
    v_and_b32_dpp v40, v144, v4 row_newbcast:6 row_mask:0xf bank_mask:0xf
    v_and_b32_dpp v41, v144, v5 row_newbcast:6 row_mask:0xf bank_mask:0xf
    v_and_b32_dpp v42, v144, v6 row_newbcast:6 row_mask:0xf bank_mask:0xf
    v_and_b32_dpp v43, v144, v7 row_newbcast:6 row_mask:0xf bank_mask:0xf
    v_add_f32 v3, v3, v145
    v_and_b32_dpp v44, v144, v4 row_newbcast:7 row_mask:0xf bank_mask:0xf
    v_and_b32_dpp v45, v144, v5 row_newbcast:7 row_mask:0xf bank_mask:0xf
    v_and_b32_dpp v46, v144, v6 row_newbcast:7 row_mask:0xf bank_mask:0xf
    v_and_b32_dpp v47, v144, v7 row_newbcast:7 row_mask:0xf bank_mask:0xf
    v_mov_b32 v145, v3
    v_and_b32_dpp v48, v144, v4 row_newbcast:8 row_mask:0xf bank_mask:0xf
    v_and_b32_dpp v49, v144, v5 row_newbcast:8 row_mask:0xf bank_mask:0xf
    v_and_b32_dpp v50, v144, v6 row_newbcast:8 row_mask:0xf bank_mask:0xf
    v_and_b32_dpp v51, v144, v7 row_newbcast:8 row_mask:0xf bank_mask:0xf
    v_permlane32_swap_b32 v145, v3
    v_and_b32_dpp v52, v144, v4 row_newbcast:9 row_mask:0xf bank_mask:0xf
    v_and_b32_dpp v53, v144, v5 row_newbcast:9 row_mask:0xf bank_mask:0xf
    v_and_b32_dpp v54, v144, v6 row_newbcast:9 row_mask:0xf bank_mask:0xf
    v_and_b32_dpp v55, v144, v7 row_newbcast:9 row_mask:0xf bank_mask:0xf
    v_add_f32 v3, v3, v145
    v_and_b32_dpp v56, v144, v4 row_newbcast:10 row_mask:0xf bank_mask:0xf
    v_and_b32_dpp v57, v144, v5 row_newbcast:10 row_mask:0xf bank_mask:0xf
    v_and_b32_dpp v58, v144, v6 row_newbcast:10 row_mask:0xf bank_mask:0xf
    v_and_b32_dpp v59, v144, v7 row_newbcast:10 row_mask:0xf bank_mask:0xf
    ds_write_b32 v13, v3 offset:528
    v_and_b32_dpp v60, v144, v4 row_newbcast:11 row_mask:0xf bank_mask:0xf
    v_and_b32_dpp v61, v144, v5 row_newbcast:11 row_mask:0xf bank_mask:0xf
    v_and_b32_dpp v62, v144, v6 row_newbcast:11 row_mask:0xf bank_mask:0xf
    v_and_b32_dpp v63, v144, v7 row_newbcast:11 row_mask:0xf bank_mask:0xf
    s_waitcnt vmcnt(5)
    buffer_load_dwordx4 v[120:123], v1, s[32:35], s38 offen offset:2048 nt
    v_and_b32_dpp v64, v144, v4 row_newbcast:12 row_mask:0xf bank_mask:0xf
    v_and_b32_dpp v65, v144, v5 row_newbcast:12 row_mask:0xf bank_mask:0xf
    v_and_b32_dpp v66, v144, v6 row_newbcast:12 row_mask:0xf bank_mask:0xf
    v_and_b32_dpp v67, v144, v7 row_newbcast:12 row_mask:0xf bank_mask:0xf
    v_and_b32_dpp v68, v144, v4 row_newbcast:13 row_mask:0xf bank_mask:0xf
    v_and_b32_dpp v69, v144, v5 row_newbcast:13 row_mask:0xf bank_mask:0xf
    v_and_b32_dpp v70, v144, v6 row_newbcast:13 row_mask:0xf bank_mask:0xf
    v_and_b32_dpp v71, v144, v7 row_newbcast:13 row_mask:0xf bank_mask:0xf
    v_and_b32_dpp v72, v144, v4 row_newbcast:14 row_mask:0xf bank_mask:0xf
    v_and_b32_dpp v73, v144, v5 row_newbcast:14 row_mask:0xf bank_mask:0xf
    v_and_b32_dpp v74, v144, v6 row_newbcast:14 row_mask:0xf bank_mask:0xf
    v_and_b32_dpp v75, v144, v7 row_newbcast:14 row_mask:0xf bank_mask:0xf
    v_and_b32_dpp v76, v144, v4 row_newbcast:15 row_mask:0xf bank_mask:0xf
    v_and_b32_dpp v77, v144, v5 row_newbcast:15 row_mask:0xf bank_mask:0xf
    v_and_b32_dpp v78, v144, v6 row_newbcast:15 row_mask:0xf bank_mask:0xf
    v_and_b32_dpp v79, v144, v7 row_newbcast:15 row_mask:0xf bank_mask:0xf
    v_mfma_f32_16x16x32_bf16 v[148:151], v[16:19], v[80:83], 0
    v_mfma_f32_16x16x32_bf16 v[148:151], v[20:23], v[84:87], v[148:151]
    v_mfma_f32_16x16x32_bf16 v[148:151], v[24:27], v[88:91], v[148:151]
    v_mfma_f32_16x16x32_bf16 v[148:151], v[28:31], v[92:95], v[148:151]
    v_mfma_f32_16x16x32_bf16 v[148:151], v[32:35], v[96:99], v[148:151]
    s_waitcnt vmcnt(6)
    buffer_load_dwordx4 v[124:127], v1, s[32:35], s38 offen offset:3072 nt
    s_waitcnt lgkmcnt(0)
    s_barrier
    ds_read_b128 v[212:215], v14 offset:512
    ds_read_b128 v[8:11], v14 offset:528
    v_mov_b32 v154, s51
    v_mov_b32 v155, s51
    s_waitcnt lgkmcnt(1)
    v_max3_f32 v2, v212, v213, v214
    v_max_f32 v2, v2, v215
    v_sub_f32 v212, v212, v2
    v_sub_f32 v213, v213, v2
    v_sub_f32 v214, v214, v2
    v_sub_f32 v215, v215, v2
    v_mul_f32 v212, 0x3fb8aa3b, v212
    v_mul_f32 v213, 0x3fb8aa3b, v213
    v_mul_f32 v214, 0x3fb8aa3b, v214
    v_mul_f32 v215, 0x3fb8aa3b, v215
    v_exp_f32 v212, v212
    v_exp_f32 v213, v213
    v_exp_f32 v214, v214
    v_exp_f32 v215, v215
    v_bfi_b32 v152, 63, s58, v2
    s_waitcnt lgkmcnt(0)
    v_mul_f32 v3, v8, v212
    v_fmac_f32 v3, v9, v213
    v_fmac_f32 v3, v10, v214
    v_fmac_f32 v3, v11, v215
    v_bfi_b32 v153, 63, s59, v3
    s_mov_b64 exec, s[16:17]
    global_store_dwordx4 v207, v[152:155], s[46:47]
    s_cmp_gt_u32 s50, 2
    s_cbranch_scc0 L_nearml
    global_store_dwordx4 v207, v[152:155], s[62:63] sc1
L_nearml:
    s_mov_b64 exec, -1
L_noml:
    s_waitcnt vmcnt(6)
    buffer_load_dwordx4 v[128:131], v1, s[32:35], s39 offen offset:0 nt
    v_mfma_f32_16x16x32_bf16 v[148:151], v[36:39], v[100:103], v[148:151]
    v_mfma_f32_16x16x32_bf16 v[148:151], v[40:43], v[104:107], v[148:151]
    s_waitcnt vmcnt(6)
    buffer_load_dwordx4 v[132:135], v1, s[32:35], s39 offen offset:1024 nt
    v_mfma_f32_16x16x32_bf16 v[148:151], v[44:47], v[108:111], v[148:151]
    s_waitcnt vmcnt(6)
    buffer_load_dwordx4 v[136:139], v1, s[32:35], s39 offen offset:2048 nt
    v_mfma_f32_16x16x32_bf16 v[148:151], v[48:51], v[112:115], v[148:151]
    s_waitcnt vmcnt(6)
    buffer_load_dwordx4 v[140:143], v1, s[32:35], s39 offen offset:3072 nt
    v_mfma_f32_16x16x32_bf16 v[148:151], v[52:55], v[116:119], v[148:151]
    s_waitcnt vmcnt(6)
    buffer_load_dwordx4 v[160:163], v200, s[12:15], s45 offen nt
    s_add_u32 s45, s45, 5120
    v_mfma_f32_16x16x32_bf16 v[148:151], v[56:59], v[120:123], v[148:151]
    s_waitcnt vmcnt(5)
    buffer_load_dwordx4 v[164:167], v200, s[12:15], s45 offen nt
    s_add_u32 s45, s45, 5120
    v_mfma_f32_16x16x32_bf16 v[148:151], v[60:63], v[124:127], v[148:151]
    s_waitcnt vmcnt(5)
    buffer_load_dwordx4 v[168:171], v200, s[12:15], s45 offen nt
    s_add_u32 s45, s45, 5120
    buffer_load_dwordx4 v[172:175], v200, s[12:15], s45 offen nt
    s_add_u32 s45, s45, 5120
    s_waitcnt vmcnt(7)
    v_mfma_f32_16x16x32_bf16 v[148:151], v[64:67], v[128:131], v[148:151]
    s_waitcnt vmcnt(6)
    v_mfma_f32_16x16x32_bf16 v[148:151], v[68:71], v[132:135], v[148:151]
    s_waitcnt vmcnt(5)
    v_mfma_f32_16x16x32_bf16 v[148:151], v[72:75], v[136:139], v[148:151]
    s_waitcnt vmcnt(4)
    v_mfma_f32_16x16x32_bf16 v[148:151], v[76:79], v[140:143], v[148:151]
    s_mov_b32 exec_hi, 0
    s_cmp_gt_u32 s50, 2
    s_nop 5
    ds_write_b128 v208, v[148:151] offset:1024
    s_waitcnt lgkmcnt(0)
    s_barrier
    ds_read2st64_b32 v[16:17], v203 offset0:4 offset1:6
    ds_read2st64_b32 v[18:19], v203 offset0:8 offset1:10
    s_waitcnt lgkmcnt(1)
    v_mul_f32 v16, v16, v212
    v_fmac_f32 v16, v17, v213
    s_waitcnt lgkmcnt(0)
    v_fmac_f32 v16, v18, v214
    v_fmac_f32 v16, v19, v215
    v_bfi_b32 v16, 63, v211, v16
    global_store_dword v206, v16, s[46:47]
    s_cbranch_scc1 L_far2
L_near2:
    s_mov_b32 exec_hi, -1
    s_cmp_eq_u32 s52, 1
    s_cbranch_scc0 L_noto
    global_load_dwordx4 v[216:219], v202, s[96:97] sc1
    global_load_dwordx4 v[8:11], v201, s[96:97] sc1
    buffer_load_dwordx4 v[176:179], v200, s[12:15], s45 offen nt
    s_add_u32 s45, s45, 5120
    buffer_load_dwordx4 v[180:183], v200, s[12:15], s45 offen nt
    s_add_u32 s45, s45, 5120
    buffer_load_dwordx4 v[184:187], v200, s[12:15], s45 offen nt
    s_add_u32 s45, s45, 5120
    buffer_load_dwordx4 v[188:191], v200, s[12:15], s45 offen nt
    s_waitcnt vmcnt(5)
L_ml:
    v_xor_b32 v2, s58, v216
    v_xor_b32 v3, s59, v217
    v_xor_b32 v218, s51, v218
    v_xor_b32 v219, s51, v219
    v_max_f32_dpp v12, v2, v2 row_ror:8 row_mask:0xf bank_mask:0xf
    v_or_b32 v1, v2, v3
    v_and_b32 v1, 63, v1
    v_or3_b32 v1, v1, v218, v219
    v_cmp_ne_u32 vcc, 0, v1
    v_mov_b32 v1, v12
    s_cbranch_vccnz L_ml_retry
L_ml_ok:
    s_nop 0
    v_permlane16_swap_b32 v12, v1
    v_max_f32 v1, v1, v12
    v_mov_b32 v12, v1
    s_nop 1
    v_permlane32_swap_b32 v12, v1
    v_max_f32 v1, v1, v12
    v_sub_f32 v2, v2, v1
    v_mul_f32 v2, 0x3fb8aa3b, v2
    v_exp_f32 v2, v2
    s_nop 0
    v_mul_f32 v3, v3, v2
    s_nop 1
    v_add_f32_dpp v3, v3, v3 row_ror:8 row_mask:0xf bank_mask:0xf
    v_mov_b32 v12, v3
    s_nop 1
    v_permlane16_swap_b32 v12, v3
    v_add_f32 v3, v3, v12
    v_mov_b32 v12, v3
    s_nop 1
    v_permlane32_swap_b32 v12, v3
    v_add_f32 v3, v3, v12
    v_rcp_f32 v3, v3
    s_nop 0
    v_mul_f32 v197, v2, v3
    s_waitcnt vmcnt(4)
    s_branch L_g2
L_g2_retry:
    s_waitcnt vmcnt(2)
    global_load_dwordx4 v[8:11], v201, s[96:97] sc1
    s_add_u32 s98, s98, 1
    s_and_b32 s99, s98, 31
    s_cselect_b64 s[96:97], s[46:47], s[62:63]
    s_sub_i32 s42, s42, 1
    s_cmp_gt_i32 s42, 0
    s_waitcnt vmcnt(0)
    s_cbranch_scc0 L_g2_ok
L_g2:
    v_xor_b32 v8, s58, v8
    v_xor_b32 v9, s59, v9
    v_xor_b32 v10, s60, v10
    v_xor_b32 v11, s61, v11
    v_or3_b32 v1, v8, v9, v10
    v_or_b32 v1, v1, v11
    v_and_b32 v1, 63, v1
    v_cmp_ne_u32 vcc, 0, v1
    v_mul_f32 v8, v8, v197
    v_mul_f32 v9, v9, v197
    v_mul_f32 v10, v10, v197
    v_mul_f32 v11, v11, v197
    s_cbranch_vccnz L_g2_retry
L_g2_ok:
    v_permlane32_swap_b32 v8, v10
    v_permlane32_swap_b32 v9, v11
    v_add_f32 v8, v8, v10
    v_add_f32 v9, v9, v11
    s_nop 1
    v_permlane16_swap_b32 v8, v9
    v_add_f32 v8, v8, v9
    s_nop 1
    v_add_f32_dpp v8, v8, v8 row_ror:8 row_mask:0xf bank_mask:0xf
    v_cvt_pk_bf16_f32 v196, v8, v8
L_proj:
    s_nop 1
    v_and_b32_dpp v40, v196, v4 row_newbcast:0 row_mask:0xf bank_mask:0xf
    v_and_b32_dpp v41, v196, v5 row_newbcast:0 row_mask:0xf bank_mask:0xf
    v_and_b32_dpp v42, v196, v6 row_newbcast:0 row_mask:0xf bank_mask:0xf
    v_and_b32_dpp v43, v196, v7 row_newbcast:0 row_mask:0xf bank_mask:0xf
    v_and_b32_dpp v44, v196, v4 row_newbcast:1 row_mask:0xf bank_mask:0xf
    v_and_b32_dpp v45, v196, v5 row_newbcast:1 row_mask:0xf bank_mask:0xf
    v_and_b32_dpp v46, v196, v6 row_newbcast:1 row_mask:0xf bank_mask:0xf
    v_and_b32_dpp v47, v196, v7 row_newbcast:1 row_mask:0xf bank_mask:0xf
    s_waitcnt vmcnt(8)
    v_mfma_f32_16x16x32_bf16 v[192:195], v[40:43], v[160:163], 0
    v_and_b32_dpp v48, v196, v4 row_newbcast:2 row_mask:0xf bank_mask:0xf
    v_and_b32_dpp v49, v196, v5 row_newbcast:2 row_mask:0xf bank_mask:0xf
    v_and_b32_dpp v50, v196, v6 row_newbcast:2 row_mask:0xf bank_mask:0xf
    v_and_b32_dpp v51, v196, v7 row_newbcast:2 row_mask:0xf bank_mask:0xf
    s_waitcnt vmcnt(7)
    v_mfma_f32_16x16x32_bf16 v[192:195], v[44:47], v[164:167], v[192:195]
    v_and_b32_dpp v52, v196, v4 row_newbcast:3 row_mask:0xf bank_mask:0xf
    v_and_b32_dpp v53, v196, v5 row_newbcast:3 row_mask:0xf bank_mask:0xf
    v_and_b32_dpp v54, v196, v6 row_newbcast:3 row_mask:0xf bank_mask:0xf
    v_and_b32_dpp v55, v196, v7 row_newbcast:3 row_mask:0xf bank_mask:0xf
    s_waitcnt vmcnt(6)
    v_mfma_f32_16x16x32_bf16 v[192:195], v[48:51], v[168:171], v[192:195]
    v_and_b32_dpp v56, v196, v4 row_newbcast:4 row_mask:0xf bank_mask:0xf
    v_and_b32_dpp v57, v196, v5 row_newbcast:4 row_mask:0xf bank_mask:0xf
    v_and_b32_dpp v58, v196, v6 row_newbcast:4 row_mask:0xf bank_mask:0xf
    v_and_b32_dpp v59, v196, v7 row_newbcast:4 row_mask:0xf bank_mask:0xf
    s_waitcnt vmcnt(5)
    v_mfma_f32_16x16x32_bf16 v[192:195], v[52:55], v[172:175], v[192:195]
    v_and_b32_dpp v60, v196, v4 row_newbcast:5 row_mask:0xf bank_mask:0xf
    v_and_b32_dpp v61, v196, v5 row_newbcast:5 row_mask:0xf bank_mask:0xf
    v_and_b32_dpp v62, v196, v6 row_newbcast:5 row_mask:0xf bank_mask:0xf
    v_and_b32_dpp v63, v196, v7 row_newbcast:5 row_mask:0xf bank_mask:0xf
    s_waitcnt vmcnt(3)
    v_mfma_f32_16x16x32_bf16 v[192:195], v[56:59], v[176:179], v[192:195]
    v_and_b32_dpp v64, v196, v4 row_newbcast:6 row_mask:0xf bank_mask:0xf
    v_and_b32_dpp v65, v196, v5 row_newbcast:6 row_mask:0xf bank_mask:0xf
    v_and_b32_dpp v66, v196, v6 row_newbcast:6 row_mask:0xf bank_mask:0xf
    v_and_b32_dpp v67, v196, v7 row_newbcast:6 row_mask:0xf bank_mask:0xf
    s_waitcnt vmcnt(2)
    v_mfma_f32_16x16x32_bf16 v[192:195], v[60:63], v[180:183], v[192:195]
    v_and_b32_dpp v68, v196, v4 row_newbcast:7 row_mask:0xf bank_mask:0xf
    v_and_b32_dpp v69, v196, v5 row_newbcast:7 row_mask:0xf bank_mask:0xf
    v_and_b32_dpp v70, v196, v6 row_newbcast:7 row_mask:0xf bank_mask:0xf
    v_and_b32_dpp v71, v196, v7 row_newbcast:7 row_mask:0xf bank_mask:0xf
    s_waitcnt vmcnt(1)
    v_mfma_f32_16x16x32_bf16 v[192:195], v[64:67], v[184:187], v[192:195]
    s_waitcnt vmcnt(0)
    v_mfma_f32_16x16x32_bf16 v[192:195], v[68:71], v[188:191], v[192:195]
    v_mov_b32 v24, 1.0
    s_mov_b32 exec_hi, 0
    s_cmp_eq_u32 s52, 0
    s_nop 4
    ds_write_b128 v208, v[192:195] offset:3072
    s_mov_b32 exec_hi, -1
    s_waitcnt lgkmcnt(0)
    s_barrier
    ds_read2st64_b32 v[20:21], v209 offset0:12 offset1:14
    ds_read2st64_b32 v[22:23], v209 offset0:16 offset1:18
    s_cbranch_scc1 L_ffn_out
    s_waitcnt lgkmcnt(1)
    v_add_f32 v20, v20, v21
    s_waitcnt lgkmcnt(0)
    v_add_f32 v22, v22, v23
    v_add_f32 v20, v20, v22
L_last:
    v_cndmask_b32 v20, v24, v20, s[48:49]
    global_atomic_add_f32 v21, v205, v20, s[26:27] sc0 sc1
    s_waitcnt vmcnt(0)
L_fin:
    v_mov_b32_dpp v3, v21 row_shl:4 row_mask:0xf bank_mask:0xf
    v_add_f32 v20, v20, v21
    v_cmp_eq_f32 vcc, 0x42680000, v3
    v_cvt_pk_bf16_f32 v20, v20, v20
    s_and_b64 vcc, vcc, s[48:49]
    s_and_saveexec_b64 s[54:55], vcc
    s_cbranch_execz L_mdone
    global_store_short v210, v20, s[22:23]
    s_endpgm
L_ml_retry:
    s_sub_i32 s42, s42, 1
    s_add_u32 s98, s98, 1
    s_and_b32 s99, s98, 31
    s_cselect_b64 s[96:97], s[46:47], s[62:63]
    s_cmp_gt_i32 s42, 0
    s_cbranch_scc1 L_ml_again
    s_branch L_ml_ok
L_ml_again:
    global_load_dwordx4 v[216:219], v202, s[96:97] sc1
    global_load_dwordx4 v[8:11], v201, s[96:97] sc1
    s_waitcnt vmcnt(0)
    s_branch L_ml
L_ffn_out:
    s_waitcnt lgkmcnt(0)
    v_add_f32 v20, v20, v21
    s_cmp_eq_u32 s41, 7
    s_cbranch_scc1 L_last
    v_add_f32 v22, v22, v23
    v_cndmask_b32 v22, v24, v22, s[48:49]
    global_atomic_add_f32 v23, v205, v22, s[26:27] offset:2048 sc0 sc1
    v_cndmask_b32 v20, v24, v20, s[48:49]
    global_atomic_add_f32 v21, v205, v20, s[26:27] sc0 sc1
    s_waitcnt vmcnt(0)
    v_mov_b32_dpp v3, v23 row_shl:4 row_mask:0xf bank_mask:0xf
    v_add_f32 v22, v22, v23
    v_cmp_eq_f32 vcc, 0x42680000, v3
    v_cvt_pk_bf16_f32 v22, v22, v22
    s_and_b64 vcc, vcc, s[48:49]
    s_and_saveexec_b64 s[54:55], vcc
    s_cbranch_execz L_second
    global_store_short v210, v22, s[22:23] offset:256
L_second:
    s_mov_b64 exec, -1
    s_branch L_fin
L_noto:
    s_cmp_eq_u32 s52, 0
    s_cbranch_scc0 L_mdone
    buffer_load_dwordx4 v[176:179], v200, s[12:15], s45 offen nt
    s_add_u32 s45, s45, 5120
    buffer_load_dwordx4 v[180:183], v200, s[12:15], s45 offen nt
    s_add_u32 s45, s45, 5120
    buffer_load_dwordx4 v[184:187], v200, s[12:15], s45 offen nt
    s_add_u32 s45, s45, 5120
    buffer_load_dwordx4 v[188:191], v200, s[12:15], s45 offen nt
    ds_read_b32 v196, v15 offset:256
    s_waitcnt lgkmcnt(0)
    s_branch L_proj
L_far2:
    global_store_dword v206, v16, s[62:63] sc1
    s_branch L_near2
L_mdone:
L_end:
    s_endpgm
.section .rodata,"a"
.p2align 6
.amdhsa_kernel parallel_sum__sliding_block_cached__glu_gated_glu__decode_kernel
  .amdhsa_next_free_vgpr 224
  .amdhsa_next_free_sgpr 102
  .amdhsa_accum_offset 224
  .amdhsa_group_segment_fixed_size 0
  .amdhsa_kernarg_size 96
  .amdhsa_user_sgpr_count 2
  .amdhsa_user_sgpr_kernarg_segment_ptr 1
  .amdhsa_system_sgpr_workgroup_id_x 1
  .amdhsa_float_denorm_mode_32 3
.end_amdhsa_kernel
```
